```python
import torch

def _softmax(x, axis=-1):
    return torch.softmax(x, dim=axis)
def _gelu(x):
    return torch.nn.functional.gelu(x, approximate="tanh")
def _silu(x):
    return torch.nn.functional.silu(x)
def _sigmoid(x):
    return torch.sigmoid(x)
def _layernorm(x, axis=-1, eps=1e-5):
    m = x.mean(dim=axis, keepdim=True)
    v = x.var(dim=axis, keepdim=True, unbiased=False)
    return (x - m) / torch.sqrt(v + eps)
def _scatter_add(tgt, idx, src, axis=0):
    return tgt.clone().index_add_(axis, idx, src)
def _segment_sum(src, seg, n):
    out = torch.zeros((n,) + src.shape[1:], dtype=src.dtype)
    return out.index_add_(0, seg, src)
def _pad(x, pw):
    flat = tuple(v for pair in reversed(pw) for v in pair)
    return torch.nn.functional.pad(x, flat)

kernel_name = 'standalone__moe_arch_mod__sampling'

def setup_inputs():

    _w = (lambda a: (lambda t: t.to(torch.bfloat16) if t.is_floating_point() else t)(torch.as_tensor(a)))
    B, S, D, F, C = 8, 32, 1024, 3584, 1
    return {
        "x": _w((lambda *s: torch.randn(*s, dtype=torch.bfloat16) * 0.1)(B, S, D)),
        "w_r": _w((lambda *s: torch.randn(*s, dtype=torch.bfloat16) * 0.1)(D)),
        "w_gate": _w((lambda *s: torch.randn(*s, dtype=torch.bfloat16) * 0.1)(D, F)),
        "w_up": _w((lambda *s: torch.randn(*s, dtype=torch.bfloat16) * 0.1)(D, F)),
        "w_down": _w((lambda *s: torch.randn(*s, dtype=torch.bfloat16) * 0.1)(F, D)),
    }

def reference(x, w_r, w_gate, w_up, w_down):
    B, S, D = x.shape
    C = 1
    r = x @ w_r
    idx = torch.argsort(-r, axis=-1)[:, :C]
    idx_e = (lambda x, n, axis: torch.repeat_interleave(x, n, dim=axis))(idx.reshape(B, C, 1), D, axis=2)
    x_sel = (lambda x, i, axis: torch.take_along_dim(x, i, dim=axis))(x, idx_e, axis=1)
    g = _silu(x_sel @ w_gate)
    u = x_sel @ w_up
    y = (g * u) @ w_down
    r_sel = _sigmoid((lambda x, i, axis: torch.take_along_dim(x, i, dim=axis))(r, idx, axis=1))
    y = y * r_sel.reshape(B, C, 1)
    b_off = (torch.arange(B) * S).reshape(B, 1)
    flat_idx = (idx + b_off).reshape(B * C)
    zero = (x * 0.0).reshape(B * S, D)
    upd = _scatter_add(zero, flat_idx, y.reshape(B * C, D), axis=0)
    return x + upd.reshape(B, S, D)
```

```asm
; @launch grid=(256,1,1) block=(320,1,1) lds=108992
.amdgcn_target "amdgcn-amd-amdhsa--gfx950"
.text
.globl standalone__moe_arch_mod__sampling_kernel
.p2align 12
.fill 832, 4, 0xbf810000
.p2align 8
.type standalone__moe_arch_mod__sampling_kernel,@function
standalone__moe_arch_mod__sampling_kernel:
    s_load_dwordx16 s[4:19], s[0:1], 0
    s_getpc_b64 s[20:21]
L_pf_base:
    v_lshlrev_b32 v7, 7, v0
    v_cmp_gt_u32 vcc, L_code_end-L_pf_base, v7
    s_and_saveexec_b64 s[22:23], vcc
    s_cbranch_execz L_ipf2
    s_cmp_ge_u32 s2, 8
    s_cbranch_scc1 L_ipf2
    global_load_dword v119, v7, s[20:21]
L_ipf2:
    s_mov_b64 exec, s[22:23]
    v_readfirstlane_b32 s3, v0
    v_and_b32 v0, 63, v0
    s_cmp_ge_u32 s2, 256
    s_cbranch_scc1 L_end
    s_and_b32 s20, s2, 7
    s_lshr_b32 s21, s2, 3
    s_lshr_b32 s3, s3, 6
    s_cmp_eq_u32 s3, 4
    s_cbranch_scc0 L_cmp
    s_setprio 3
    s_sub_u32 s26, s20, 1
    s_lshl_b32 s27, s26, 5
    s_add_u32 s27, s27, s21
    v_lshlrev_b32 v7, 4, v0
    s_lshl_b32 s28, s27, 13
    s_add_u32 s29, s28, 4096
    v_mov_b32 v1, 0
    v_mov_b32 v3, 108928
    v_mov_b32 v2, 0
    ds_write_b32 v3, v1 offset:4
    ds_write2_b32 v3, v1, v2 offset0:2 offset1:3
    s_mov_b32 s46, 524288
    s_mov_b32 s47, 0x20000
    s_movk_i32 s50, 2048
    s_mov_b32 s51, s47
    s_mov_b32 s58, 2802944
    s_mov_b32 s59, s47
    s_mov_b32 s30, 2801664
    s_mov_b32 s36, 2768896
    s_sub_u32 s37, s2, 230
    s_cmp_lt_u32 s26, 2
    s_waitcnt lgkmcnt(0)
    s_mov_b64 s[44:45], s[4:5]
    s_cbranch_scc0 L_norl
    s_mov_b64 s[48:49], s[6:7]
    buffer_load_dwordx4 v[16:19], v7, s[44:47], s28 offen offset:0 nt
    buffer_load_dwordx4 v[48:51], v7, s[48:51], 0 offen
    buffer_load_dwordx4 v[52:55], v7, s[48:51], 0 offen offset:1024
    buffer_load_dwordx4 v[20:23], v7, s[44:47], s28 offen offset:1024 nt
    buffer_load_dwordx4 v[24:27], v7, s[44:47], s28 offen offset:2048 nt
    buffer_load_dwordx4 v[28:31], v7, s[44:47], s28 offen offset:3072 nt
    buffer_load_dwordx4 v[32:35], v7, s[44:47], s29 offen offset:0 nt
    buffer_load_dwordx4 v[36:39], v7, s[44:47], s29 offen offset:1024 nt
    buffer_load_dwordx4 v[40:43], v7, s[44:47], s29 offen offset:2048 nt
    buffer_load_dwordx4 v[44:47], v7, s[44:47], s29 offen offset:3072 nt
L_norl:
    s_add_u32 s56, s18, 264241152
    s_addc_u32 s57, s19, 0
    s_load_dword s33, s[56:57], s30
    s_add_u32 s30, s30, 128
    s_load_dword s35, s[56:57], s30
    s_cmp_eq_u32 s37, 0
    s_cbranch_scc0 L_nopt
    v_lshlrev_b32 v13, 5, v0
    s_mov_b32 s37, 2760704
    buffer_load_dword v2, v13, s[56:59], s37 offen
    v_lshlrev_b32 v13, 5, v0
    v_cmp_gt_u32 vcc, 32, v0
    s_and_saveexec_b64 s[42:43], vcc
    buffer_load_dword v4, v13, s[56:59], s36 offen
    s_mov_b64 exec, -1
L_nopt:
    s_barrier
    s_branch L_ctl
L_cmp:
    s_lshl_b32 s22, s20, 2
    s_lshr_b32 s22, 0x3b652104, s22
    s_and_b32 s27, s22, 3
    s_mov_b64 s[24:25], 0
    s_lshr_b32 s23, s21, 3
    s_lshl2_add_u32 s29, s27, s23
    s_and_b32 s23, s21, 7
    s_and_b32 s28, s22, 12
    s_cbranch_scc0 L_dnc
    s_bitcmp1_b32 s22, 2
    s_cselect_b32 s28, 24, 12
    s_sub_u32 s23, s21, s28
    s_cbranch_scc1 L_dsc
    s_lshr_b32 s25, s23, 4
    s_lshr_b32 s29, s23, 3
    s_add_u32 s29, s29, s27
    s_add_u32 s29, s29, 16
    s_and_b32 s23, s23, 7
L_dnc:
    s_add_u32 s22, s29, 2
    s_mul_i32 s22, s22, 43
    s_lshr_b32 s22, s22, 7
    s_add_u32 s22, s22, s29
    s_branch L_decc
L_dsc:
    s_cmp_ge_u32 s21, 12
    s_cselect_b32 s28, 12, 0
    s_addc_u32 s29, s27, s27
    s_sub_u32 s23, s21, s28
    s_lshl2_add_u32 s22, s29, 1
    s_mov_b32 s24, 1
L_decc:
    s_cmp_ge_u32 s23, 4
    s_cselect_b32 s28, 4, 0
    s_cselect_b32 s24, s24, 0
    s_addc_u32 s22, s22, s22
    s_sub_u32 s23, s23, s28
    s_and_b32 s41, s23, s24
    s_cmp_eq_u32 s25, 1
    s_cbranch_scc1 L_end
    v_lshrrev_b32 v5, 3, v0
    v_lshrrev_b32 v2, 4, v0
    v_and_b32 v1, 3, v5
    v_lshrrev_b32 v3, 5, v0
    v_lshl_add_u32 v1, v3, 3, v1
    v_lshlrev_b32 v3, 1, v2
    v_xor_b32 v3, v3, v0
    v_and_b32 v3, 7, v3
    v_lshlrev_b32 v3, 4, v3
    v_mul_u32_u24 v4, 7168, v1
    v_add_u32 v4, v4, v3
    s_and_b32 s28, s3, 1
    s_lshl_b32 s28, s28, 4
    s_lshr_b32 s29, s3, 1
    s_lshl_b32 s29, s29, 2
    s_add_u32 s28, s28, s29
    s_add_u32 s30, s24, 1
    s_lshl_b32 s31, s24, 1
    s_or_b32 s31, s31, 1
    s_sub_u32 s32, 9, s24
    s_lshr_b32 s33, s23, s30
    s_and_b32 s34, s23, s31
    s_lshl_b32 s35, s34, s32
    s_add_u32 s36, s35, s28
    s_mul_i32 s36, s36, 7168
    s_lshl_b32 s37, s22, 7
    s_add_u32 s36, s36, s37
    s_mov_b32 s26, s36
    s_lshl_b32 s27, 7168, s32
    s_add_u32 s27, s27, s36
    s_mov_b32 s37, 0x6622
    s_cmp_eq_u32 s24, 1
    s_cselect_b32 s37, 0x55553333, s37
    s_lshl_b32 s35, s23, 2
    s_lshr_b32 s37, s37, s35
    s_and_b32 s37, s37, 15
    s_mul_i32 s37, s37, 229376
    s_add_u32 s36, s36, s37
    s_lshl_b32 m0, s3, 10
    s_mov_b32 s46, 7340032
    s_mov_b32 s47, 0x20000
    s_cmp_eq_u32 s33, 1
    s_waitcnt lgkmcnt(0)
    s_cselect_b32 s44, s10, s8
    s_cselect_b32 s45, s11, s9
    v_mov_b32 v13, 108928
    s_cmp_eq_u32 s24, 1
    s_mov_b32 s43, 2
    s_barrier
L_b0:
    buffer_load_dwordx4 v4, s[44:47], s36 offen nt lds
    s_add_u32 s36, s36, 229376
    s_add_u32 m0, m0, 4096
    s_cmp_eq_u32 s36, s27
    s_cselect_b32 s36, s26, s36
    s_sub_u32 s43, s43, 1
    s_cmp_lg_u32 s43, 0
    s_cbranch_scc1 L_b0
    s_cmp_eq_u32 s24, 1
    s_cbranch_scc1 L_slow
    s_mov_b32 s48, s12
    s_mov_b32 s49, s13
    s_mov_b32 s50, 7340032
    s_mov_b32 s51, 0x20000
    s_lshr_b32 s38, s23, s24
    s_and_b32 s40, s22, 1
    s_lshl2_add_u32 s40, s40, s38
    s_lshr_b32 s38, s22, 1
    s_lshr_b32 s39, s3, 1
    s_lshl1_add_u32 s39, s38, s39
    s_lshl_b32 s39, s39, 17
    s_and_b32 s42, s3, 1
    s_lshl3_add_u32 s42, s42, s40
    s_lshl_b32 s42, s42, 8
    v_bfe_u32 v3, v0, 4, 1
    s_and_b32 s43, s3, 1
    s_lshl_b32 s43, s43, 1
    v_or_b32 v3, s43, v3
    v_lshlrev_b32 v3, 1, v3
    v_xor_b32 v3, v3, v0
    v_and_b32 v3, 7, v3
    v_lshlrev_b32 v3, 4, v3
    v_lshrrev_b32 v5, 5, v0
    v_lshl_add_u32 v3, v5, 7, v3
    v_bfe_u32 v5, v0, 3, 2
    v_lshl_add_u32 v5, v5, 15, v3
    s_add_u32 s39, s39, s42
    s_lshl_b32 s42, s3, 10
    s_add_u32 s42, s42, 65536
    v_lshrrev_b32 v1, 5, v0
    v_and_b32 v3, 31, v0
    v_bfe_u32 v6, v0, 2, 3
    v_lshlrev_b32 v7, 7, v6
    v_lshl_add_u32 v7, v1, 10, v7
    v_lshrrev_b32 v6, 1, v6
    v_lshl_add_u32 v7, v6, 5, v7
    v_and_b32 v6, 3, v0
    v_lshl_add_u32 v7, v6, 3, v7
    s_lshl_b32 s43, s3, 5
    v_xor_b32 v6, s43, v7
    v_bfe_u32 v3, v0, 2, 2
    v_lshlrev_b32 v7, 7, v3
    v_lshl_add_u32 v7, v2, 10, v7
    v_bfe_u32 v3, v0, 3, 2
    v_lshl_add_u32 v7, v3, 5, v7
    v_and_b32 v3, 3, v0
    v_lshl_add_u32 v7, v3, 3, v7
    s_and_b32 s43, s3, 1
    s_lshl_b32 s43, s43, 6
    v_xor_b32 v7, s43, v7
    s_lshr_b32 s43, s3, 1
    s_lshl_b32 s43, s43, 9
    s_add_u32 s43, s43, 65536
    v_add_u32 v7, s43, v7
    v_and_b32 v8, 7, v0
    v_bfe_u32 v9, v0, 3, 1
    v_mul_u32_u24 v10, 1056, v8
    v_lshl_add_u32 v10, v2, 4, v10
    v_mul_u32_u24 v11, 512, v9
    v_add_u32 v10, v10, v11
    v_add_u32 v10, 98304, v10
    s_lshl_b32 s60, s22, 3
    s_lshl_b32 s52, s33, 2
    s_add_u32 s52, s52, s60
    s_add_u32 s52, s52, s34
    s_lshl_b32 s52, s52, 11
    s_lshl_b32 s53, s3, 9
    s_add_u32 s52, s52, s53
    s_add_u32 s56, s18, 264241152
    s_addc_u32 s57, s19, 0
    s_mov_b32 s58, 2802944
    s_mov_b32 s59, 0x20000
    v_lshlrev_b32 v14, 6, v8
    v_lshl_add_u32 v14, v2, 4, v14
    v_mov_b32 v15, 1023
    buffer_load_dwordx4 v4, s[44:47], s36 offen nt lds
    s_add_u32 m0, m0, 4096
    s_add_u32 s36, s36, 229376
    s_cmp_eq_u32 s36, s27
    s_cselect_b32 s36, s26, s36
    buffer_load_dwordx4 v4, s[44:47], s36 offen nt lds
    s_add_u32 m0, m0, 4096
    s_add_u32 s36, s36, 229376
    s_cmp_eq_u32 s36, s27
    s_cselect_b32 s36, s26, s36
    buffer_load_dwordx4 v4, s[44:47], s36 offen nt lds
    s_add_u32 m0, m0, 4096
    s_add_u32 s36, s36, 229376
    s_cmp_eq_u32 s36, s27
    s_cselect_b32 s36, s26, s36
    s_bitcmp1_b32 s3, 0
    s_cbranch_scc1 T_pubn
    s_cmp_eq_u32 s3, 2
    s_cbranch_scc1 T_mid
    s_branch T_gatn
T_backn:
    s_mov_b32 s35, 11
    s_mov_b32 s37, 160000
    s_mov_b32 s30, 4
    s_mov_b32 s34, -2
L_bln:
    ds_read_b32 v12, v13 offset:4
    s_waitcnt vmcnt(4)
    buffer_load_dwordx4 v4, s[44:47], s36 offen nt lds
    s_add_u32 m0, m0, 4096
    s_add_u32 s36, s36, 229376
    s_cmp_eq_u32 s36, s27
    s_cselect_b32 s36, s26, s36
    s_sub_u32 s35, s35, 1
    s_cmp_eq_u32 s35, 0
    s_cbranch_scc1 L_cl0n
    s_waitcnt lgkmcnt(0)
    v_readfirstlane_b32 s43, v12
    s_sub_u32 s37, s37, 1
    s_cbranch_scc1 L_bgn
    s_cmp_eq_u32 s43, 0
    s_cbranch_scc1 L_bln
L_bgn:
    s_cmp_gt_u32 s35, 16
    s_cselect_b32 s34, 0, -2
    s_cmp_ge_u32 s35, 6
    s_cselect_b32 s30, 0, s30
L_bhn:
    buffer_load_dwordx4 v4, s[44:47], s36 offen nt lds
    s_add_u32 m0, m0, 4096
    s_add_u32 s36, s36, 229376
    s_cmp_eq_u32 s36, s27
    s_cselect_b32 s36, s26, s36
    s_sub_u32 s35, s35, 1
    s_cmp_lg_u32 s35, 0
    s_cbranch_scc1 L_bhn
L_cl0n:
    s_mov_b32 m0, s42
    v_mov_b32 v11, 1
    s_mov_b32 s35, 8
    s_mov_b32 s31, 0
    s_cmp_eq_u32 s31, 1
    s_cbranch_scc1 L_st_2b
    ds_read_b32 v12, v13 offset:4
    s_waitcnt vmcnt(4) lgkmcnt(0)
    v_readfirstlane_b32 s43, v12
    s_and_b32 s43, s43, s34
    s_cbranch_scc1 L_st_2a
    buffer_load_dwordx4 v5, s[48:51], s39 offen nt lds
    s_add_u32 m0, m0, 4096
    s_add_u32 s39, s39, 4096
    s_sub_u32 s35, s35, 1
    ds_read_b32 v12, v13 offset:4
    s_waitcnt vmcnt(4) lgkmcnt(0)
    v_readfirstlane_b32 s43, v12
    s_and_b32 s43, s43, s34
    s_cbranch_scc1 L_st_2a
    buffer_load_dwordx4 v5, s[48:51], s39 offen nt lds
    s_add_u32 m0, m0, 4096
    s_add_u32 s39, s39, 4096
    s_sub_u32 s35, s35, 1
    ds_read_b32 v12, v13 offset:4
    s_waitcnt vmcnt(4) lgkmcnt(0)
    v_readfirstlane_b32 s43, v12
    s_and_b32 s43, s43, s34
    s_cbranch_scc1 L_st_2a
    buffer_load_dwordx4 v5, s[48:51], s39 offen nt lds
    s_add_u32 m0, m0, 4096
    s_add_u32 s39, s39, 4096
    s_sub_u32 s35, s35, 1
    ds_read_b32 v12, v13 offset:4
    s_waitcnt vmcnt(4) lgkmcnt(0)
    v_readfirstlane_b32 s43, v12
    s_and_b32 s43, s43, s34
    s_cbranch_scc1 L_st_2a
    buffer_load_dwordx4 v5, s[48:51], s39 offen nt lds
    s_add_u32 m0, m0, 4096
    s_add_u32 s39, s39, 4096
    s_sub_u32 s35, s35, 1
    s_waitcnt vmcnt(5)
    s_branch L_st_2c
L_st_2a:
    s_mov_b32 s31, 1
L_bu_3:
    buffer_load_dwordx4 v5, s[48:51], s39 offen nt lds
    s_add_u32 m0, m0, 4096
    s_add_u32 s39, s39, 4096
    s_sub_u32 s35, s35, 1
    s_cmp_gt_u32 s35, s30
    s_cbranch_scc1 L_bu_3
L_st_2b:
    s_cmp_eq_u32 s30, 0
    s_waitcnt vmcnt(9)
    s_cbranch_scc1 L_st_2c
    s_waitcnt vmcnt(5)
L_st_2c:
    s_mov_b64 exec, 1
    ds_add_rtn_u32 v12, v13, v11 offset:8
    s_mov_b64 exec, -1
    s_waitcnt lgkmcnt(0)
    v_readfirstlane_b32 s43, v12
    s_cmp_ge_u32 s43, 3
    s_cbranch_scc1 L_cs_4x
L_cs_4:
    ds_read_b32 v12, v13 offset:8
    s_waitcnt lgkmcnt(0)
    v_readfirstlane_b32 s43, v12
    s_cmp_lt_u32 s43, 4
    s_cbranch_scc1 L_cs_4
L_cs_4x:
    ds_read_b64_tr_b16 v[48:49], v6 offset:0
    ds_read_b64_tr_b16 v[50:51], v6 offset:2048
    ds_read_b64_tr_b16 v[52:53], v6 offset:4096
    ds_read_b64_tr_b16 v[54:55], v6 offset:6144
    ds_read_b64_tr_b16 v[56:57], v6 offset:8192
    ds_read_b64_tr_b16 v[58:59], v6 offset:10240
    ds_read_b64_tr_b16 v[60:61], v6 offset:12288
    ds_read_b64_tr_b16 v[62:63], v6 offset:14336
    ds_read_b64_tr_b16 v[64:65], v6 offset:16384
    ds_read_b64_tr_b16 v[66:67], v6 offset:18432
    ds_read_b64_tr_b16 v[68:69], v6 offset:20480
    ds_read_b64_tr_b16 v[70:71], v6 offset:22528
    ds_read_b64_tr_b16 v[72:73], v6 offset:24576
    ds_read_b64_tr_b16 v[74:75], v6 offset:26624
    ds_read_b64_tr_b16 v[76:77], v6 offset:28672
    ds_read_b64_tr_b16 v[78:79], v6 offset:30720
    ds_read_b64_tr_b16 v[80:81], v6 offset:32768
    ds_read_b64_tr_b16 v[82:83], v6 offset:34816
    ds_read_b64_tr_b16 v[84:85], v6 offset:36864
    ds_read_b64_tr_b16 v[86:87], v6 offset:38912
    ds_read_b64_tr_b16 v[88:89], v6 offset:40960
    ds_read_b64_tr_b16 v[90:91], v6 offset:43008
    ds_read_b64_tr_b16 v[92:93], v6 offset:45056
    ds_read_b64_tr_b16 v[94:95], v6 offset:47104
    ds_read_b64_tr_b16 v[96:97], v6 offset:49152
    ds_read_b64_tr_b16 v[98:99], v6 offset:51200
    ds_read_b64_tr_b16 v[100:101], v6 offset:53248
    ds_read_b64_tr_b16 v[102:103], v6 offset:55296
    ds_read_b64_tr_b16 v[104:105], v6 offset:57344
    ds_read_b64_tr_b16 v[106:107], v6 offset:59392
    s_cmp_eq_u32 s31, 1
    s_cbranch_scc1 L_st_5b
    s_waitcnt vmcnt(4)
    s_branch L_st_5c
.fill 8, 4, 0xbf800000
T_mid:
    s_branch T_backn
L_st_5a:
    s_mov_b32 s31, 1
L_bu_6:
    buffer_load_dwordx4 v5, s[48:51], s39 offen nt lds
    s_add_u32 m0, m0, 4096
    s_add_u32 s39, s39, 4096
    s_sub_u32 s35, s35, 1
    s_cmp_gt_u32 s35, s30
    s_cbranch_scc1 L_bu_6
L_st_5b:
    s_cmp_eq_u32 s30, 0
    s_waitcnt vmcnt(8)
    s_cbranch_scc1 L_st_5c
    s_waitcnt vmcnt(4)
L_st_5c:
    s_cmp_eq_u32 s35, 0
    s_cbranch_scc1 L_noc_1h
    s_cmp_eq_u32 s34, 0
    s_cbranch_scc1 L_noc_1h
    s_cmp_eq_u32 s31, 1
    s_cbranch_scc1 L_noc_1i
L_cxn:
    ds_read_b32 v12, v13 offset:4
    s_waitcnt vmcnt(4) lgkmcnt(0)
    v_readfirstlane_b32 s43, v12
    s_and_b32 s43, s43, s34
    s_cbranch_scc1 L_noc_1i
    buffer_load_dwordx4 v5, s[48:51], s39 offen nt lds
    s_add_u32 m0, m0, 4096
    s_add_u32 s39, s39, 4096
    s_sub_u32 s35, s35, 1
    s_cmp_gt_u32 s35, 0
    s_cbranch_scc1 L_cxn
    s_branch L_noc_1h
L_noc_1i:
L_bu_7:
    buffer_load_dwordx4 v5, s[48:51], s39 offen nt lds
    s_add_u32 m0, m0, 4096
    s_add_u32 s39, s39, 4096
    s_sub_u32 s35, s35, 1
    s_cmp_gt_u32 s35, 0
    s_cbranch_scc1 L_bu_7
L_noc_1h:
    s_waitcnt lgkmcnt(0)
    s_barrier
    ds_read_b128 v[16:19], v10 offset:0
    ds_read_b128 v[20:23], v10 offset:64
    ds_read_b128 v[24:27], v10 offset:128
    ds_read_b128 v[28:31], v10 offset:192
    ds_read_b128 v[32:35], v10 offset:256
    ds_read_b128 v[36:39], v10 offset:320
    ds_read_b128 v[40:43], v10 offset:384
    ds_read_b128 v[44:47], v10 offset:448
    ds_read_b64_tr_b16 v[108:109], v6 offset:61440
    ds_read_b64_tr_b16 v[110:111], v6 offset:63488
    ds_read_b32 v12, v13
    ds_read_b32 v11, v13 offset:16
    s_waitcnt lgkmcnt(11)
    v_mfma_f32_16x16x32_bf16 v[112:115], v[48:51], v[16:19], 0
    v_mfma_f32_16x16x32_bf16 v[116:119], v[80:83], v[16:19], 0
    s_waitcnt lgkmcnt(10)
    v_mfma_f32_16x16x32_bf16 v[112:115], v[52:55], v[20:23], v[112:115]
    v_mfma_f32_16x16x32_bf16 v[116:119], v[84:87], v[20:23], v[116:119]
    s_waitcnt lgkmcnt(9)
    v_mfma_f32_16x16x32_bf16 v[112:115], v[56:59], v[24:27], v[112:115]
    v_mfma_f32_16x16x32_bf16 v[116:119], v[88:91], v[24:27], v[116:119]
    s_waitcnt lgkmcnt(8)
    v_mfma_f32_16x16x32_bf16 v[112:115], v[60:63], v[28:31], v[112:115]
    v_mfma_f32_16x16x32_bf16 v[116:119], v[92:95], v[28:31], v[116:119]
    s_waitcnt lgkmcnt(7)
    v_mfma_f32_16x16x32_bf16 v[112:115], v[64:67], v[32:35], v[112:115]
    v_mfma_f32_16x16x32_bf16 v[116:119], v[96:99], v[32:35], v[116:119]
    s_waitcnt lgkmcnt(6)
    v_mfma_f32_16x16x32_bf16 v[112:115], v[68:71], v[36:39], v[112:115]
    v_mfma_f32_16x16x32_bf16 v[116:119], v[100:103], v[36:39], v[116:119]
    s_waitcnt lgkmcnt(5)
    v_mfma_f32_16x16x32_bf16 v[112:115], v[72:75], v[40:43], v[112:115]
    v_mfma_f32_16x16x32_bf16 v[116:119], v[104:107], v[40:43], v[116:119]
    s_waitcnt lgkmcnt(2)
    v_mfma_f32_16x16x32_bf16 v[112:115], v[76:79], v[44:47], v[112:115]
    v_mfma_f32_16x16x32_bf16 v[116:119], v[108:111], v[44:47], v[116:119]
    s_waitcnt lgkmcnt(0)
    s_branch L_pub
L_slow:
    s_mov_b32 s48, s12
    s_mov_b32 s49, s13
    s_mov_b32 s50, 7340032
    s_mov_b32 s51, 0x20000
    s_lshr_b32 s38, s23, s24
    s_and_b32 s40, s22, 1
    s_lshl2_add_u32 s40, s40, s38
    s_lshr_b32 s38, s22, 1
    s_lshr_b32 s39, s3, 1
    s_lshl1_add_u32 s39, s38, s39
    s_lshl_b32 s39, s39, 17
    s_and_b32 s42, s3, 1
    s_lshl3_add_u32 s42, s42, s40
    s_lshl_b32 s42, s42, 8
    v_bfe_u32 v3, v0, 4, 1
    s_and_b32 s43, s3, 1
    s_lshl_b32 s43, s43, 1
    v_or_b32 v3, s43, v3
    v_lshlrev_b32 v3, 1, v3
    v_xor_b32 v3, v3, v0
    v_and_b32 v3, 7, v3
    v_lshlrev_b32 v3, 4, v3
    v_lshrrev_b32 v5, 5, v0
    v_lshl_add_u32 v3, v5, 7, v3
    v_bfe_u32 v5, v0, 3, 2
    v_lshl_add_u32 v5, v5, 15, v3
    s_add_u32 s39, s39, s42
    s_lshl_b32 s42, s3, 10
    s_add_u32 s42, s42, 65536
    v_lshrrev_b32 v1, 5, v0
    v_and_b32 v3, 31, v0
    v_bfe_u32 v6, v0, 2, 3
    v_lshlrev_b32 v7, 7, v6
    v_lshl_add_u32 v7, v1, 10, v7
    v_lshrrev_b32 v6, 1, v6
    v_lshl_add_u32 v7, v6, 5, v7
    v_and_b32 v6, 3, v0
    v_lshl_add_u32 v7, v6, 3, v7
    s_lshl_b32 s43, s3, 5
    v_xor_b32 v6, s43, v7
    v_bfe_u32 v3, v0, 2, 2
    v_lshlrev_b32 v7, 7, v3
    v_lshl_add_u32 v7, v2, 10, v7
    v_bfe_u32 v3, v0, 3, 2
    v_lshl_add_u32 v7, v3, 5, v7
    v_and_b32 v3, 3, v0
    v_lshl_add_u32 v7, v3, 3, v7
    s_and_b32 s43, s3, 1
    s_lshl_b32 s43, s43, 6
    v_xor_b32 v7, s43, v7
    s_lshr_b32 s43, s3, 1
    s_lshl_b32 s43, s43, 9
    s_add_u32 s43, s43, 65536
    v_add_u32 v7, s43, v7
    v_and_b32 v8, 7, v0
    v_bfe_u32 v9, v0, 3, 1
    v_mul_u32_u24 v10, 1056, v8
    v_lshl_add_u32 v10, v2, 4, v10
    v_mul_u32_u24 v11, 256, v9
    v_add_u32 v10, v10, v11
    s_and_b32 s43, s34, 1
    s_lshl_b32 s43, s43, 9
    s_add_u32 s43, s43, 98304
    v_add_u32 v10, s43, v10
    s_lshl_b32 s60, s22, 3
    s_lshl_b32 s52, s33, 2
    s_add_u32 s52, s52, s60
    s_add_u32 s52, s52, s34
    s_lshl_b32 s52, s52, 11
    s_lshl_b32 s53, s3, 9
    s_add_u32 s52, s52, s53
    s_add_u32 s56, s18, 264241152
    s_addc_u32 s57, s19, 0
    s_mov_b32 s58, 2802944
    s_mov_b32 s59, 0x20000
    v_lshlrev_b32 v14, 6, v8
    v_lshl_add_u32 v14, v2, 4, v14
    v_mov_b32 v15, 1023
    buffer_load_dwordx4 v4, s[44:47], s36 offen nt lds
    s_add_u32 m0, m0, 4096
    s_add_u32 s36, s36, 229376
    s_cmp_eq_u32 s36, s27
    s_cselect_b32 s36, s26, s36
    s_bitcmp1_b32 s3, 0
    s_cbranch_scc1 T_pubs
    s_branch T_gats
T_backs:
    s_mov_b32 s35, 5
    s_mov_b32 s37, 160000
    s_mov_b32 s30, 4
    s_mov_b32 s34, -2
L_bls:
    ds_read_b32 v12, v13 offset:4
    s_waitcnt vmcnt(2)
    buffer_load_dwordx4 v4, s[44:47], s36 offen nt lds
    s_add_u32 m0, m0, 4096
    s_add_u32 s36, s36, 229376
    s_cmp_eq_u32 s36, s27
    s_cselect_b32 s36, s26, s36
    s_sub_u32 s35, s35, 1
    s_cmp_eq_u32 s35, 0
    s_cbranch_scc1 L_cl0s
    s_waitcnt lgkmcnt(0)
    v_readfirstlane_b32 s43, v12
    s_sub_u32 s37, s37, 1
    s_cbranch_scc1 L_bgs
    s_cmp_eq_u32 s43, 0
    s_cbranch_scc1 L_bls
L_bgs:
    s_cmp_gt_u32 s35, 8
    s_cselect_b32 s34, 0, -2
    s_cmp_ge_u32 s35, 3
    s_cselect_b32 s30, 0, s30
L_bhs:
    buffer_load_dwordx4 v4, s[44:47], s36 offen nt lds
    s_add_u32 m0, m0, 4096
    s_add_u32 s36, s36, 229376
    s_cmp_eq_u32 s36, s27
    s_cselect_b32 s36, s26, s36
    s_sub_u32 s35, s35, 1
    s_cmp_lg_u32 s35, 0
    s_cbranch_scc1 L_bhs
L_cl0s:
    s_mov_b32 m0, s42
    v_mov_b32 v11, 1
    s_mov_b32 s35, 8
    s_mov_b32 s31, 0
    s_cmp_eq_u32 s41, 1
    s_cbranch_scc1 L_noc_8d
    s_cmp_eq_u32 s31, 1
    s_cbranch_scc1 L_st_9b
    ds_read_b32 v12, v13 offset:4
    s_waitcnt vmcnt(2) lgkmcnt(0)
    v_readfirstlane_b32 s43, v12
    s_and_b32 s43, s43, s34
    s_cbranch_scc1 L_st_9a
    buffer_load_dwordx4 v5, s[48:51], s39 offen nt lds
    s_add_u32 m0, m0, 4096
    s_add_u32 s39, s39, 4096
    s_sub_u32 s35, s35, 1
    ds_read_b32 v12, v13 offset:4
    s_waitcnt vmcnt(2) lgkmcnt(0)
    v_readfirstlane_b32 s43, v12
    s_and_b32 s43, s43, s34
    s_cbranch_scc1 L_st_9a
    buffer_load_dwordx4 v5, s[48:51], s39 offen nt lds
    s_add_u32 m0, m0, 4096
    s_add_u32 s39, s39, 4096
    s_sub_u32 s35, s35, 1
    s_waitcnt vmcnt(2)
    s_branch L_st_9c
L_st_9a:
    s_mov_b32 s31, 1
L_bu_10:
    buffer_load_dwordx4 v5, s[48:51], s39 offen nt lds
    s_add_u32 m0, m0, 4096
    s_add_u32 s39, s39, 4096
    s_sub_u32 s35, s35, 1
    s_cmp_gt_u32 s35, s30
    s_cbranch_scc1 L_bu_10
L_st_9b:
    s_cmp_eq_u32 s30, 0
    s_waitcnt vmcnt(8)
    s_cbranch_scc1 L_st_9c
    s_waitcnt vmcnt(4)
L_st_9c:
    s_branch L_noc_8e
L_noc_8d:
    s_waitcnt vmcnt(0)
L_noc_8e:
    s_mov_b64 exec, 1
    ds_add_rtn_u32 v12, v13, v11 offset:12
    s_mov_b64 exec, -1
    s_waitcnt lgkmcnt(0)
    v_readfirstlane_b32 s43, v12
    s_cmp_ge_u32 s43, 3
    s_cbranch_scc1 L_cs_11x
L_cs_11:
    ds_read_b32 v12, v13 offset:12
    s_waitcnt lgkmcnt(0)
    v_readfirstlane_b32 s43, v12
    s_cmp_lt_u32 s43, 4
    s_cbranch_scc1 L_cs_11
L_cs_11x:
    ds_read_b64_tr_b16 v[48:49], v6 offset:0
    ds_read_b64_tr_b16 v[50:51], v6 offset:2048
    ds_read_b64_tr_b16 v[52:53], v6 offset:4096
    ds_read_b64_tr_b16 v[54:55], v6 offset:6144
    ds_read_b64_tr_b16 v[56:57], v6 offset:8192
    ds_read_b64_tr_b16 v[58:59], v6 offset:10240
    ds_read_b64_tr_b16 v[60:61], v6 offset:12288
    ds_read_b64_tr_b16 v[62:63], v6 offset:14336
    ds_read_b64_tr_b16 v[64:65], v6 offset:16384
    ds_read_b64_tr_b16 v[66:67], v6 offset:18432
    ds_read_b64_tr_b16 v[68:69], v6 offset:20480
    ds_read_b64_tr_b16 v[70:71], v6 offset:22528
    ds_read_b64_tr_b16 v[72:73], v6 offset:24576
    ds_read_b64_tr_b16 v[74:75], v6 offset:26624
    ds_read_b64_tr_b16 v[76:77], v6 offset:28672
    ds_read_b64_tr_b16 v[78:79], v6 offset:30720
    s_cmp_eq_u32 s41, 1
    s_cbranch_scc1 L_noc_8h
    s_cmp_eq_u32 s35, 0
    s_cbranch_scc1 L_noc_8h
    s_cmp_eq_u32 s34, 0
    s_cbranch_scc1 L_noc_8h
    s_cmp_eq_u32 s31, 1
    s_cbranch_scc1 L_noc_8i
L_cxs:
    ds_read_b32 v12, v13 offset:4
    s_waitcnt vmcnt(2) lgkmcnt(0)
    v_readfirstlane_b32 s43, v12
    s_and_b32 s43, s43, s34
    s_cbranch_scc1 L_noc_8i
    s_sub_u32 s37, s37, 1
    s_cbranch_scc1 L_noc_8i
    s_cmp_le_u32 s35, 4
    s_cbranch_scc1 L_cxs
    buffer_load_dwordx4 v5, s[48:51], s39 offen nt lds
    s_add_u32 m0, m0, 4096
    s_add_u32 s39, s39, 4096
    s_sub_u32 s35, s35, 1
    s_cmp_gt_u32 s35, 0
    s_cbranch_scc1 L_cxs
    s_branch L_noc_8h
L_noc_8i:
L_bu_12:
    buffer_load_dwordx4 v5, s[48:51], s39 offen nt lds
    s_add_u32 m0, m0, 4096
    s_add_u32 s39, s39, 4096
    s_sub_u32 s35, s35, 1
    s_cmp_gt_u32 s35, 0
    s_cbranch_scc1 L_bu_12
L_noc_8h:
    s_waitcnt lgkmcnt(0)
    s_barrier
    ds_read_b128 v[16:19], v10 offset:0
    ds_read_b128 v[20:23], v10 offset:64
    ds_read_b128 v[24:27], v10 offset:128
    ds_read_b128 v[28:31], v10 offset:192
    ds_read_b32 v12, v13
    ds_read_b32 v11, v13 offset:16
    s_waitcnt lgkmcnt(5)
    v_mfma_f32_16x16x32_bf16 v[112:115], v[48:51], v[16:19], 0
    v_mfma_f32_16x16x32_bf16 v[116:119], v[64:67], v[16:19], 0
    s_waitcnt lgkmcnt(4)
    v_mfma_f32_16x16x32_bf16 v[112:115], v[52:55], v[20:23], v[112:115]
    v_mfma_f32_16x16x32_bf16 v[116:119], v[68:71], v[20:23], v[116:119]
    s_waitcnt lgkmcnt(3)
    v_mfma_f32_16x16x32_bf16 v[112:115], v[56:59], v[24:27], v[112:115]
    v_mfma_f32_16x16x32_bf16 v[116:119], v[72:75], v[24:27], v[116:119]
    s_waitcnt lgkmcnt(2)
    v_mfma_f32_16x16x32_bf16 v[112:115], v[60:63], v[28:31], v[112:115]
    v_mfma_f32_16x16x32_bf16 v[116:119], v[76:79], v[28:31], v[116:119]
    s_waitcnt lgkmcnt(0)
    s_branch L_pub
.p2align 6
.fill 32, 4, 0xbf800000
T_pubn:
    s_branch T_backn
T_pubs:
    s_branch T_backs
L_pub:
    s_and_b32 s53, s3, 1
    s_lshl1_add_u32 s60, s38, s53
    s_lshl_b32 s62, s60, 14
    s_lshr_b32 s53, s3, 1
    s_lshl_b32 s53, s53, 8
    s_add_u32 s62, s62, s53
    s_add_u32 s63, s62, 8192
    s_add_u32 s54, s62, 4096
    s_add_u32 s55, s63, 4096
    v_add_f32_dpp v112, v116, v112 row_ror:8 row_mask:0xf bank_mask:0xf
    v_add_f32_dpp v113, v117, v113 row_ror:8 row_mask:0xf bank_mask:0xf
    v_add_f32_dpp v114, v118, v114 row_ror:8 row_mask:0xf bank_mask:0xf
    v_add_f32_dpp v115, v119, v115 row_ror:8 row_mask:0xf bank_mask:0xf
    s_mov_b32 exec_lo, 0x00ff00ff
    s_mov_b32 exec_hi, 0x00ff00ff
    v_bfi_b32 v112, v15, v12, v112
    v_bfi_b32 v113, v15, v12, v113
    v_bfi_b32 v114, v15, v12, v114
    v_bfi_b32 v115, v15, v12, v115
    v_readfirstlane_b32 s33, v11
    buffer_store_dwordx4 v[112:115], v14, s[56:59], s52 offen
    s_cmp_eq_u32 s33, 1
    s_cselect_b32 s32, 0, 917504
    s_cbranch_scc1 L_pub1
    s_add_u32 s52, s52, s32
    buffer_store_dwordx4 v[112:115], v14, s[56:59], s52 offen sc1
L_pub1:
    s_mov_b64 exec, -1
    s_cmp_eq_u32 s41, 1
    s_cbranch_scc1 L_cdone
    s_mov_b32 s37, s35
    s_cmp_eq_u32 s35, 0
    s_cbranch_scc1 L_clx
L_cll:
    buffer_load_dwordx4 v5, s[48:51], s39 offen nt lds
    s_add_u32 m0, m0, 4096
    s_add_u32 s39, s39, 4096
    s_sub_u32 s35, s35, 1
    s_cmp_lg_u32 s35, 0
    s_cbranch_scc1 L_cll
L_clx:
    v_bfe_u32 v18, v0, 2, 2
    v_and_b32 v3, 3, v0
    v_lshlrev_b32 v14, 9, v2
    v_lshl_add_u32 v14, v18, 6, v14
    v_lshl_add_u32 v14, v3, 4, v14
    v_mul_u32_u24 v16, 272, v8
    v_lshl_add_u32 v16, v2, 4, v16
    v_add_u32 v16, 106752, v16
    v_mul_u32_u24 v17, 272, v18
    v_lshl_add_u32 v17, v3, 6, v17
    v_lshl_add_u32 v17, v2, 1, v17
    s_lshr_b32 s52, s3, 1
    s_mul_i32 s52, s52, 1088
    s_and_b32 s53, s3, 1
    s_lshl_b32 s53, s53, 5
    s_add_u32 s52, s52, s53
    s_add_u32 s52, s52, 106752
    v_add_u32 v17, s52, v17
    v_xor_b32 v37, 32, v7
    v_mul_u32_u24 v19, 14336, v8
    v_lshl_add_u32 v19, v9, 6, v19
    v_lshl_add_u32 v19, v2, 4, v19
    s_lshl2_add_u32 s52, s40, s3
    s_and_b32 s53, s52, 7
    s_cmp_eq_u32 s53, s20
    s_cselect_b32 s33, s33, 0
    s_lshr_b32 s52, s52, 3
    s_lshl_b32 s53, s53, 5
    s_add_u32 s52, s52, s53
    s_mul_i32 s52, s52, 3584
    s_lshl_b32 s53, s38, 7
    s_add_u32 s52, s52, s53
    s_add_u32 s52, s52, 1835008
    s_mov_b32 s61, 20000
    s_and_b32 s60, s60, 7
    s_cmp_eq_u32 s60, 3
    s_cbranch_scc0 L_gnorm
    s_waitcnt vmcnt(1)
    s_cmp_ge_u32 s37, 1
    s_cbranch_scc1 L_gws
    s_waitcnt vmcnt(1)
L_gws:
    buffer_load_dwordx4 v[20:23], v14, s[56:59], s62 offen offset:0 sc1
    buffer_load_dwordx4 v[24:27], v14, s[56:59], s62 offen offset:2048 sc1
    buffer_load_dwordx4 v[28:31], v14, s[56:59], s63 offen offset:0 sc1
    buffer_load_dwordx4 v[32:35], v14, s[56:59], s63 offen offset:2048 sc1
    buffer_load_dwordx4 v[88:91], v14, s[56:59], s54 offen offset:0 sc1
    buffer_load_dwordx4 v[92:95], v14, s[56:59], s54 offen offset:2048 sc1
    buffer_load_dwordx4 v[96:99], v14, s[56:59], s55 offen offset:0 sc1
    buffer_load_dwordx4 v[100:103], v14, s[56:59], s55 offen offset:2048 sc1
    s_cmp_eq_u32 s37, 0
    s_cbranch_scc0 L_gxs
    s_waitcnt vmcnt(9)
    s_branch L_gys
L_gxs:
    s_waitcnt vmcnt(8)
L_gys:
    s_barrier
    ds_read_b64_tr_b16 v[48:49], v7 offset:0
    ds_read_b64_tr_b16 v[50:51], v7 offset:4096
    ds_read_b64_tr_b16 v[52:53], v37 offset:0
    ds_read_b64_tr_b16 v[54:55], v37 offset:4096
    ds_read_b64_tr_b16 v[56:57], v7 offset:8192
    ds_read_b64_tr_b16 v[58:59], v7 offset:12288
    ds_read_b64_tr_b16 v[60:61], v37 offset:8192
    ds_read_b64_tr_b16 v[62:63], v37 offset:12288
    ds_read_b64_tr_b16 v[64:65], v7 offset:16384
    ds_read_b64_tr_b16 v[66:67], v7 offset:20480
    ds_read_b64_tr_b16 v[68:69], v37 offset:16384
    ds_read_b64_tr_b16 v[70:71], v37 offset:20480
    ds_read_b64_tr_b16 v[72:73], v7 offset:24576
    ds_read_b64_tr_b16 v[74:75], v7 offset:28672
    ds_read_b64_tr_b16 v[76:77], v37 offset:24576
    ds_read_b64_tr_b16 v[78:79], v37 offset:28672
    s_branch L_gcs
L_gs:
    s_add_u32 s62, s62, s32
    s_add_u32 s63, s63, s32
    s_add_u32 s54, s54, s32
    s_add_u32 s55, s55, s32
    s_sub_u32 s32, 0, s32
    buffer_load_dwordx4 v[20:23], v14, s[56:59], s62 offen offset:0 sc1
    buffer_load_dwordx4 v[24:27], v14, s[56:59], s62 offen offset:2048 sc1
    buffer_load_dwordx4 v[28:31], v14, s[56:59], s63 offen offset:0 sc1
    buffer_load_dwordx4 v[32:35], v14, s[56:59], s63 offen offset:2048 sc1
    buffer_load_dwordx4 v[88:91], v14, s[56:59], s54 offen offset:0 sc1
    buffer_load_dwordx4 v[92:95], v14, s[56:59], s54 offen offset:2048 sc1
    buffer_load_dwordx4 v[96:99], v14, s[56:59], s55 offen offset:0 sc1
    buffer_load_dwordx4 v[100:103], v14, s[56:59], s55 offen offset:2048 sc1
L_gcs:
    s_waitcnt vmcnt(7)
    v_xor_b32 v18, v20, v12
    v_bitop3_b32 v18, v18, v21, v12 bitop3:0xf6
    v_bitop3_b32 v18, v18, v22, v12 bitop3:0xf6
    v_bitop3_b32 v18, v18, v23, v12 bitop3:0xf6
    s_waitcnt vmcnt(6)
    v_bitop3_b32 v18, v18, v24, v12 bitop3:0xf6
    v_bitop3_b32 v18, v18, v25, v12 bitop3:0xf6
    v_bitop3_b32 v18, v18, v26, v12 bitop3:0xf6
    v_bitop3_b32 v18, v18, v27, v12 bitop3:0xf6
    s_waitcnt vmcnt(5)
    v_bitop3_b32 v18, v18, v28, v12 bitop3:0xf6
    v_bitop3_b32 v18, v18, v29, v12 bitop3:0xf6
    v_bitop3_b32 v18, v18, v30, v12 bitop3:0xf6
    v_bitop3_b32 v18, v18, v31, v12 bitop3:0xf6
    s_waitcnt vmcnt(4)
    v_bitop3_b32 v18, v18, v32, v12 bitop3:0xf6
    v_bitop3_b32 v18, v18, v33, v12 bitop3:0xf6
    v_bitop3_b32 v18, v18, v34, v12 bitop3:0xf6
    v_bitop3_b32 v18, v18, v35, v12 bitop3:0xf6
    s_waitcnt vmcnt(3)
    v_bitop3_b32 v18, v18, v88, v12 bitop3:0xf6
    v_bitop3_b32 v18, v18, v89, v12 bitop3:0xf6
    v_bitop3_b32 v18, v18, v90, v12 bitop3:0xf6
    v_bitop3_b32 v18, v18, v91, v12 bitop3:0xf6
    s_waitcnt vmcnt(2)
    v_bitop3_b32 v18, v18, v92, v12 bitop3:0xf6
    v_bitop3_b32 v18, v18, v93, v12 bitop3:0xf6
    v_bitop3_b32 v18, v18, v94, v12 bitop3:0xf6
    v_bitop3_b32 v18, v18, v95, v12 bitop3:0xf6
    s_waitcnt vmcnt(1)
    v_bitop3_b32 v18, v18, v96, v12 bitop3:0xf6
    v_bitop3_b32 v18, v18, v97, v12 bitop3:0xf6
    v_bitop3_b32 v18, v18, v98, v12 bitop3:0xf6
    v_bitop3_b32 v18, v18, v99, v12 bitop3:0xf6
    s_waitcnt vmcnt(0)
    v_bitop3_b32 v18, v18, v100, v12 bitop3:0xf6
    v_bitop3_b32 v18, v18, v101, v12 bitop3:0xf6
    v_bitop3_b32 v18, v18, v102, v12 bitop3:0xf6
    v_bitop3_b32 v18, v18, v103, v12 bitop3:0xf6
    v_and_b32 v18, v15, v18
    v_cmp_ne_u32 vcc, 0, v18
    s_cbranch_vccz L_goks
    s_sub_u32 s61, s61, 1
    s_cmp_lg_u32 s61, 0
    s_cbranch_scc1 L_gs
L_goks:
    v_pk_add_f32 v[20:21], v[20:21], v[88:89]
    v_pk_add_f32 v[22:23], v[22:23], v[90:91]
    v_pk_add_f32 v[24:25], v[24:25], v[92:93]
    v_pk_add_f32 v[26:27], v[26:27], v[94:95]
    v_pk_add_f32 v[28:29], v[28:29], v[96:97]
    v_pk_add_f32 v[30:31], v[30:31], v[98:99]
    v_pk_add_f32 v[32:33], v[32:33], v[100:101]
    v_pk_add_f32 v[34:35], v[34:35], v[102:103]
    s_branch L_act
T_gatn:
    s_branch T_backn
T_gats:
    s_branch T_backs
L_gnorm:
    s_waitcnt vmcnt(1)
    s_cmp_ge_u32 s37, 1
    s_cbranch_scc1 L_gwn
    s_waitcnt vmcnt(1)
L_gwn:
    buffer_load_dwordx4 v[20:23], v14, s[56:59], s62 offen offset:0 sc1
    buffer_load_dwordx4 v[24:27], v14, s[56:59], s62 offen offset:2048 sc1
    buffer_load_dwordx4 v[28:31], v14, s[56:59], s63 offen offset:0 sc1
    buffer_load_dwordx4 v[32:35], v14, s[56:59], s63 offen offset:2048 sc1
    s_cmp_eq_u32 s37, 0
    s_cbranch_scc0 L_gxn
    s_waitcnt vmcnt(5)
    s_branch L_gyn
L_gxn:
    s_waitcnt vmcnt(4)
L_gyn:
    s_barrier
    ds_read_b64_tr_b16 v[48:49], v7 offset:0
    ds_read_b64_tr_b16 v[50:51], v7 offset:4096
    ds_read_b64_tr_b16 v[52:53], v37 offset:0
    ds_read_b64_tr_b16 v[54:55], v37 offset:4096
    ds_read_b64_tr_b16 v[56:57], v7 offset:8192
    ds_read_b64_tr_b16 v[58:59], v7 offset:12288
    ds_read_b64_tr_b16 v[60:61], v37 offset:8192
    ds_read_b64_tr_b16 v[62:63], v37 offset:12288
    ds_read_b64_tr_b16 v[64:65], v7 offset:16384
    ds_read_b64_tr_b16 v[66:67], v7 offset:20480
    ds_read_b64_tr_b16 v[68:69], v37 offset:16384
    ds_read_b64_tr_b16 v[70:71], v37 offset:20480
    ds_read_b64_tr_b16 v[72:73], v7 offset:24576
    ds_read_b64_tr_b16 v[74:75], v7 offset:28672
    ds_read_b64_tr_b16 v[76:77], v37 offset:24576
    ds_read_b64_tr_b16 v[78:79], v37 offset:28672
    s_branch L_gcn
L_gn:
    s_add_u32 s62, s62, s32
    s_add_u32 s63, s63, s32
    s_add_u32 s54, s54, s32
    s_add_u32 s55, s55, s32
    s_sub_u32 s32, 0, s32
    buffer_load_dwordx4 v[20:23], v14, s[56:59], s62 offen offset:0 sc1
    buffer_load_dwordx4 v[24:27], v14, s[56:59], s62 offen offset:2048 sc1
    buffer_load_dwordx4 v[28:31], v14, s[56:59], s63 offen offset:0 sc1
    buffer_load_dwordx4 v[32:35], v14, s[56:59], s63 offen offset:2048 sc1
L_gcn:
    s_waitcnt vmcnt(3)
    v_xor_b32 v18, v20, v12
    v_bitop3_b32 v18, v18, v21, v12 bitop3:0xf6
    v_bitop3_b32 v18, v18, v22, v12 bitop3:0xf6
    v_bitop3_b32 v18, v18, v23, v12 bitop3:0xf6
    s_waitcnt vmcnt(2)
    v_bitop3_b32 v18, v18, v24, v12 bitop3:0xf6
    v_bitop3_b32 v18, v18, v25, v12 bitop3:0xf6
    v_bitop3_b32 v18, v18, v26, v12 bitop3:0xf6
    v_bitop3_b32 v18, v18, v27, v12 bitop3:0xf6
    s_waitcnt vmcnt(1)
    v_bitop3_b32 v18, v18, v28, v12 bitop3:0xf6
    v_bitop3_b32 v18, v18, v29, v12 bitop3:0xf6
    v_bitop3_b32 v18, v18, v30, v12 bitop3:0xf6
    v_bitop3_b32 v18, v18, v31, v12 bitop3:0xf6
    s_waitcnt vmcnt(0)
    v_bitop3_b32 v18, v18, v32, v12 bitop3:0xf6
    v_bitop3_b32 v18, v18, v33, v12 bitop3:0xf6
    v_bitop3_b32 v18, v18, v34, v12 bitop3:0xf6
    v_bitop3_b32 v18, v18, v35, v12 bitop3:0xf6
    v_and_b32 v18, v15, v18
    v_cmp_ne_u32 vcc, 0, v18
    s_cbranch_vccz L_gokn
    s_sub_u32 s61, s61, 1
    s_cmp_lg_u32 s61, 0
    s_cbranch_scc1 L_gn
L_gokn:
L_act:
    v_pk_add_f32 v[20:21], v[20:21], v[24:25]
    v_pk_add_f32 v[22:23], v[22:23], v[26:27]
    v_pk_add_f32 v[28:29], v[28:29], v[32:33]
    v_pk_add_f32 v[30:31], v[30:31], v[34:35]
    v_cvt_pk_bf16_f32 v24, v20, v21
    v_cvt_pk_bf16_f32 v25, v22, v23
    v_cvt_pk_bf16_f32 v26, v28, v29
    v_cvt_pk_bf16_f32 v27, v30, v31
    v_lshlrev_b32 v20, 16, v24
    v_and_b32 v21, 0xffff0000, v24
    v_lshlrev_b32 v22, 16, v25
    v_and_b32 v23, 0xffff0000, v25
    v_mul_f32 v32, 0xbfb8aa3b, v20
    v_mul_f32 v33, 0xbfb8aa3b, v21
    v_mul_f32 v34, 0xbfb8aa3b, v22
    v_mul_f32 v35, 0xbfb8aa3b, v23
    v_exp_f32 v32, v32
    v_exp_f32 v33, v33
    v_exp_f32 v34, v34
    v_exp_f32 v35, v35
    v_lshlrev_b32 v28, 16, v26
    v_and_b32 v29, 0xffff0000, v26
    v_add_f32 v32, 1.0, v32
    v_add_f32 v33, 1.0, v33
    v_add_f32 v34, 1.0, v34
    v_add_f32 v35, 1.0, v35
    v_rcp_f32 v32, v32
    v_rcp_f32 v33, v33
    v_rcp_f32 v34, v34
    v_rcp_f32 v35, v35
    v_lshlrev_b32 v30, 16, v27
    v_and_b32 v31, 0xffff0000, v27
    v_pk_mul_f32 v[20:21], v[20:21], v[32:33]
    v_pk_mul_f32 v[22:23], v[22:23], v[34:35]
    v_cvt_pk_bf16_f32 v24, v20, v21
    v_cvt_pk_bf16_f32 v25, v22, v23
    v_lshlrev_b32 v20, 16, v24
    v_and_b32 v21, 0xffff0000, v24
    v_lshlrev_b32 v22, 16, v25
    v_and_b32 v23, 0xffff0000, v25
    v_pk_mul_f32 v[20:21], v[20:21], v[28:29]
    v_pk_mul_f32 v[22:23], v[22:23], v[30:31]
    v_cvt_pk_bf16_f32 v24, v20, v21
    v_cvt_pk_bf16_f32 v25, v22, v23
    ds_write_b16 v17, v24
    ds_write_b16_d16_hi v17, v24 offset:16
    ds_write_b16 v17, v25 offset:8
    ds_write_b16_d16_hi v17, v25 offset:24
    v_cmp_eq_u32 vcc, 1, v9
    s_waitcnt lgkmcnt(0)
    s_barrier
    ds_read_b128 v[20:23], v16 offset:0
    ds_read_b128 v[24:27], v16 offset:64
    ds_read_b128 v[28:31], v16 offset:128
    ds_read_b128 v[32:35], v16 offset:192
    s_waitcnt lgkmcnt(3)
    v_mfma_f32_16x16x32_bf16 v[80:83], v[48:51], v[20:23], 0
    v_mfma_f32_16x16x32_bf16 v[84:87], v[52:55], v[20:23], 0
    s_waitcnt lgkmcnt(2)
    v_mfma_f32_16x16x32_bf16 v[80:83], v[56:59], v[24:27], v[80:83]
    v_mfma_f32_16x16x32_bf16 v[84:87], v[60:63], v[24:27], v[84:87]
    s_waitcnt lgkmcnt(1)
    v_mfma_f32_16x16x32_bf16 v[80:83], v[64:67], v[28:31], v[80:83]
    v_mfma_f32_16x16x32_bf16 v[84:87], v[68:71], v[28:31], v[84:87]
    s_waitcnt lgkmcnt(0)
    v_mfma_f32_16x16x32_bf16 v[80:83], v[72:75], v[32:35], v[80:83]
    v_mfma_f32_16x16x32_bf16 v[84:87], v[76:79], v[32:35], v[84:87]
    s_cmp_eq_u32 s33, 1
    s_nop 6
    v_cndmask_b32 v80, v80, v84, vcc
    v_cndmask_b32 v81, v81, v85, vcc
    v_cndmask_b32 v82, v82, v86, vcc
    v_cndmask_b32 v83, v83, v87, vcc
    v_bfi_b32 v80, v15, v12, v80
    v_bfi_b32 v81, v15, v12, v81
    v_bfi_b32 v82, v15, v12, v82
    v_bfi_b32 v83, v15, v12, v83
    s_cbranch_scc1 L_yloc
    buffer_store_dwordx4 v[80:83], v19, s[56:59], s52 offen sc1
    s_branch L_ydone
L_yloc:
    buffer_store_dwordx4 v[80:83], v19, s[56:59], s52 offen
L_ydone:
    s_barrier
L_cdone:
    s_endpgm
L_ctl:
    s_lshl_b32 s22, s20, 2
    s_lshr_b32 s22, 0x3b652104, s22
    s_and_b32 s37, s22, 3
    s_mov_b64 s[24:25], 0
    s_lshr_b32 s23, s21, 3
    s_lshl2_add_u32 s39, s37, s23
    s_and_b32 s23, s21, 7
    s_and_b32 s38, s22, 12
    s_cbranch_scc0 L_dnk
    s_bitcmp1_b32 s22, 2
    s_cselect_b32 s38, 24, 12
    s_sub_u32 s23, s21, s38
    s_cbranch_scc1 L_dsk
    s_lshr_b32 s25, s23, 4
    s_lshr_b32 s39, s23, 3
    s_add_u32 s39, s39, s37
    s_add_u32 s39, s39, 16
    s_and_b32 s23, s23, 7
L_dnk:
    s_add_u32 s22, s39, 2
    s_mul_i32 s22, s22, 43
    s_lshr_b32 s22, s22, 7
    s_add_u32 s22, s22, s39
    s_branch L_deck
L_dsk:
    s_cmp_ge_u32 s21, 12
    s_cselect_b32 s38, 12, 0
    s_addc_u32 s39, s37, s37
    s_sub_u32 s23, s21, s38
    s_lshl2_add_u32 s22, s39, 1
    s_mov_b32 s24, 1
L_deck:
    s_cmp_ge_u32 s23, 4
    s_cselect_b32 s38, 4, 0
    s_cselect_b32 s24, s24, 0
    s_addc_u32 s22, s22, s22
    s_sub_u32 s23, s23, s38
    s_and_b32 s41, s23, s24
    s_add_u32 s52, s56, s36
    s_addc_u32 s53, s57, 0
    s_lshr_b32 s37, s23, s24
    s_and_b32 s37, s37, 1
    s_lshl_b32 s37, s37, 10
    s_mov_b32 s38, 0x6622
    s_cmp_eq_u32 s24, 1
    s_cselect_b32 s38, 0x55553333, s38
    s_lshl_b32 s39, s23, 2
    s_lshr_b32 s38, s38, s39
    s_and_b32 s38, s38, 15
    s_lshl_b32 s38, s38, 6
    s_lshr_b32 s39, 1023, s24
    v_add_u32 v84, s38, v7
    v_bfi_b32 v84, s39, v84, v7
    v_add_u32 v84, s37, v84
    v_add_u32 v85, 65536, v84
    v_add_u32 v86, 131072, v84
    v_add_u32 v87, 196608, v84
    v_add_u32 v88, 262144, v84
    v_add_u32 v89, 327680, v84
    v_add_u32 v90, 393216, v84
    v_add_u32 v91, 458752, v84
    s_waitcnt lgkmcnt(0)
    s_add_u32 s33, s33, 1
    v_mov_b32 v6, s33
    s_cmp_eq_u32 s35, s33
    s_cselect_b32 s17, 1, 0
    s_cbranch_scc0 L_ontime
    v_mov_b32 v4, 1
    ds_write_b32 v3, v4 offset:4
L_ontime:
    s_sub_u32 s35, s2, 1
    s_cmp_lt_u32 s35, 2
    s_cbranch_scc0 L_nomark
    s_mov_b32 s10, s33
    s_atomic_swap s10, s[56:57], s30
L_nomark:
    s_cmp_lt_u32 s26, 2
    s_cbranch_scc1 L_route
    s_branch L_rdone
L_route:
    s_and_b32 s30, s27, 7
    s_lshl_b32 s30, s30, 13
    s_sub_u32 s30, 63488, s30
    s_lshl_b32 s31, s27, 5
    s_add_u32 s31, s31, 2760704
    s_waitcnt vmcnt(8)
    v_dot2_f32_bf16 v8, v16, v48, 0
    v_dot2_f32_bf16 v8, v17, v49, v8
    v_dot2_f32_bf16 v8, v18, v50, v8
    v_dot2_f32_bf16 v8, v19, v51, v8
    s_waitcnt vmcnt(6)
    v_dot2_f32_bf16 v8, v20, v52, v8
    v_dot2_f32_bf16 v8, v21, v53, v8
    v_dot2_f32_bf16 v8, v22, v54, v8
    v_dot2_f32_bf16 v8, v23, v55, v8
    s_waitcnt vmcnt(5)
    v_dot2_f32_bf16 v9, v24, v48, 0
    v_dot2_f32_bf16 v9, v25, v49, v9
    v_dot2_f32_bf16 v9, v26, v50, v9
    v_dot2_f32_bf16 v9, v27, v51, v9
    s_waitcnt vmcnt(4)
    v_dot2_f32_bf16 v9, v28, v52, v9
    v_dot2_f32_bf16 v9, v29, v53, v9
    v_dot2_f32_bf16 v9, v30, v54, v9
    v_dot2_f32_bf16 v9, v31, v55, v9
    s_waitcnt vmcnt(3)
    v_dot2_f32_bf16 v10, v32, v48, 0
    v_dot2_f32_bf16 v10, v33, v49, v10
    v_dot2_f32_bf16 v10, v34, v50, v10
    v_dot2_f32_bf16 v10, v35, v51, v10
    s_waitcnt vmcnt(2)
    v_dot2_f32_bf16 v10, v36, v52, v10
    v_dot2_f32_bf16 v10, v37, v53, v10
    v_dot2_f32_bf16 v10, v38, v54, v10
    v_dot2_f32_bf16 v10, v39, v55, v10
    s_waitcnt vmcnt(1)
    v_dot2_f32_bf16 v11, v40, v48, 0
    v_dot2_f32_bf16 v11, v41, v49, v11
    v_dot2_f32_bf16 v11, v42, v50, v11
    v_dot2_f32_bf16 v11, v43, v51, v11
    s_waitcnt vmcnt(0)
    v_dot2_f32_bf16 v11, v44, v52, v11
    v_dot2_f32_bf16 v11, v45, v53, v11
    v_dot2_f32_bf16 v11, v46, v54, v11
    v_dot2_f32_bf16 v11, v47, v55, v11
    s_nop 1
    s_nop 0
    v_permlane32_swap_b32 v8, v9
    v_permlane32_swap_b32 v10, v11
    v_bfe_u32 v13, v0, 4, 1
    v_add_f32 v8, v8, v9
    v_add_f32 v10, v10, v11
    v_lshrrev_b32 v14, 5, v0
    v_lshl_add_u32 v13, v13, 1, v14
    v_permlane16_swap_b32 v8, v10
    v_lshlrev_b32 v13, 11, v13
    v_add_f32 v8, v8, v10
    v_sub_u32 v12, s30, v13
    s_nop 0
    v_add_f32_dpp v8, v8, v8 row_ror:8 row_mask:0xf bank_mask:0xf
    s_nop 1
    v_add_f32_dpp v8, v8, v8 row_ror:4 row_mask:0xf bank_mask:0xf
    s_nop 1
    v_add_f32_dpp v8, v8, v8 row_ror:2 row_mask:0xf bank_mask:0xf
    s_nop 1
    v_add_f32_dpp v8, v8, v8 row_ror:1 row_mask:0xf bank_mask:0xf
    s_movk_i32 s32, 0x7ff
    v_cvt_pk_bf16_f32 v9, v8, v8
    v_cmp_u_f32 vcc, v8, v8
    v_and_or_b32 v12, v6, s32, v12
    v_ashrrev_i32 v10, 31, v9
    v_or_b32 v10, 0x80000000, v10
    v_xor_b32 v9, v9, v10
    v_cndmask_b32 v9, v9, 0, vcc
    v_and_b32 v9, 0xffff0000, v9
    v_or_b32 v8, v9, v12
    v_or_b32 v9, v9, v12
    s_nop 1
    v_permlane32_swap_b32 v8, v9
    s_nop 0
    v_max_u32 v8, v8, v9
    v_max_u32 v9, v8, v9
    s_nop 1
    v_permlane16_swap_b32 v8, v9
    v_max_u32 v10, v8, v9
    s_mov_b32 s9, s33
    v_readfirstlane_b32 s8, v10
    s_atomic_swap_x2 s[8:9], s[56:57], s31
    s_bfe_u32 s16, s8, 0x2000b
    s_xor_b32 s16, s16, 3
L_rdone:
    s_cmp_eq_u32 s2, 230
    s_cbranch_scc0 L_poll
    v_lshlrev_b32 v13, 5, v0
    s_mov_b32 s30, 2760704
    v_and_b32 v14, 1, v0
    v_lshlrev_b32 v92, 7, v14
    v_add_u32 v93, 32, v92
    v_add_u32 v94, 64, v92
    v_add_u32 v95, 96, v92
    v_lshrrev_b32 v15, 1, v0
    v_lshlrev_b32 v15, 6, v15
    v_lshl_add_u32 v15, v14, 4, v15
    s_sub_u32 s31, s21, 28
    s_lshl_b32 s31, s31, 13
    s_add_u32 s31, s31, 2768896
    s_add_u32 s32, s31, 4096
    s_mov_b32 s34, 20000
    s_waitcnt vmcnt(0) lgkmcnt(0)
    buffer_load_dwordx2 v[100:101], v13, s[56:59], s30 offen sc1
    s_sleep 2
    buffer_load_dwordx2 v[102:103], v13, s[56:59], s30 offen sc1
    s_sleep 2
L_ag:
    buffer_load_dwordx2 v[104:105], v13, s[56:59], s30 offen sc1
    s_waitcnt vmcnt(2)
    v_cmp_ne_u32 vcc, v101, v6
    v_mov_b32 v8, v100
    s_cbranch_vccz L_agok
    s_sleep 2
    buffer_load_dwordx2 v[100:101], v13, s[56:59], s30 offen sc1
    s_waitcnt vmcnt(2)
    v_cmp_ne_u32 vcc, v103, v6
    v_mov_b32 v8, v102
    s_cbranch_vccz L_agok
    s_sleep 2
    buffer_load_dwordx2 v[102:103], v13, s[56:59], s30 offen sc1
    s_waitcnt vmcnt(2)
    v_cmp_ne_u32 vcc, v105, v6
    v_mov_b32 v8, v104
    s_cbranch_vccz L_agok
    s_sleep 2
    s_sub_u32 s34, s34, 1
    s_cmp_lg_u32 s34, 0
    s_cbranch_scc1 L_ag
L_agok:
    s_nop 0
    v_max_u32_dpp v8, v8, v8 quad_perm:[1,0,3,2] row_mask:0xf bank_mask:0xf
    s_nop 1
    v_max_u32_dpp v8, v8, v8 quad_perm:[2,3,0,1] row_mask:0xf bank_mask:0xf
    s_nop 1
    v_max_u32_dpp v8, v8, v8 row_half_mirror row_mask:0xf bank_mask:0xf
    v_xor_b32 v8, 0xf800, v8
    ds_bpermute_b32 v96, v92, v8
    ds_bpermute_b32 v97, v93, v8
    ds_bpermute_b32 v98, v94, v8
    ds_bpermute_b32 v99, v95, v8
    s_waitcnt lgkmcnt(0)
    s_bfm_b64 exec, 32, 0
    buffer_store_dwordx4 v[96:99], v15, s[56:59], s36 offen sc1
    s_mov_b64 exec, -1
L_poll:
    s_getreg_b32 s35, hwreg(HW_REG_XCC_ID, 0, 4)
    s_lshl_b32 s54, s20, 8
    s_add_u32 s54, s54, 2752512
    s_lshl_b32 s55, s21, 3
    s_add_u32 s55, s55, s54
    v_lshlrev_b32 v4, 7, v0
    s_mov_b64 exec, 3
    buffer_load_dword v14, v4, s[56:59], s54 offen nt
    s_mov_b64 exec, 1
    v_mov_b32 v4, s35
    v_mov_b32 v5, v6
    buffer_store_dwordx2 v[4:5], v1, s[56:59], s55 offen
    s_mov_b64 exec, -1
    v_and_b32 v12, 1023, v6
    ds_write_b32 v3, v12
    s_mov_b32 s12, s14
    s_mov_b32 s13, s15
    s_mov_b32 s14, 524288
    s_mov_b32 s15, 0x20000
    s_cmp_lt_u32 s26, 2
    s_cbranch_scc0 L_nofix
    s_mov_b32 s32, 0x7f807f80
    s_mov_b32 s34, 0x00400040
    v_and_b32 v48, s32, v16
    v_and_b32 v49, s32, v17
    v_add_u32 v48, 0x00800080, v48
    v_add_u32 v49, 0x00800080, v49
    v_lshrrev_b32 v48, 9, v48
    v_lshrrev_b32 v49, 9, v49
    v_and_or_b32 v16, v48, s34, v16
    v_and_or_b32 v17, v49, s34, v17
    v_and_b32 v48, s32, v18
    v_and_b32 v49, s32, v19
    v_add_u32 v48, 0x00800080, v48
    v_add_u32 v49, 0x00800080, v49
    v_lshrrev_b32 v48, 9, v48
    v_lshrrev_b32 v49, 9, v49
    v_and_or_b32 v18, v48, s34, v18
    v_and_or_b32 v19, v49, s34, v19
    v_and_b32 v48, s32, v20
    v_and_b32 v49, s32, v21
    v_add_u32 v48, 0x00800080, v48
    v_add_u32 v49, 0x00800080, v49
    v_lshrrev_b32 v48, 9, v48
    v_lshrrev_b32 v49, 9, v49
    v_and_or_b32 v20, v48, s34, v20
    v_and_or_b32 v21, v49, s34, v21
    v_and_b32 v48, s32, v22
    v_and_b32 v49, s32, v23
    v_add_u32 v48, 0x00800080, v48
    v_add_u32 v49, 0x00800080, v49
    v_lshrrev_b32 v48, 9, v48
    v_lshrrev_b32 v49, 9, v49
    v_and_or_b32 v22, v48, s34, v22
    v_and_or_b32 v23, v49, s34, v23
    v_and_b32 v48, s32, v24
    v_and_b32 v49, s32, v25
    v_add_u32 v48, 0x00800080, v48
    v_add_u32 v49, 0x00800080, v49
    v_lshrrev_b32 v48, 9, v48
    v_lshrrev_b32 v49, 9, v49
    v_and_or_b32 v24, v48, s34, v24
    v_and_or_b32 v25, v49, s34, v25
    v_and_b32 v48, s32, v26
    v_and_b32 v49, s32, v27
    v_add_u32 v48, 0x00800080, v48
    v_add_u32 v49, 0x00800080, v49
    v_lshrrev_b32 v48, 9, v48
    v_lshrrev_b32 v49, 9, v49
    v_and_or_b32 v26, v48, s34, v26
    v_and_or_b32 v27, v49, s34, v27
    v_and_b32 v48, s32, v28
    v_and_b32 v49, s32, v29
    v_add_u32 v48, 0x00800080, v48
    v_add_u32 v49, 0x00800080, v49
    v_lshrrev_b32 v48, 9, v48
    v_lshrrev_b32 v49, 9, v49
    v_and_or_b32 v28, v48, s34, v28
    v_and_or_b32 v29, v49, s34, v29
    v_and_b32 v48, s32, v30
    v_and_b32 v49, s32, v31
    v_add_u32 v48, 0x00800080, v48
    v_add_u32 v49, 0x00800080, v49
    v_lshrrev_b32 v48, 9, v48
    v_lshrrev_b32 v49, 9, v49
    v_and_or_b32 v30, v48, s34, v30
    v_and_or_b32 v31, v49, s34, v31
    v_and_b32 v48, s32, v32
    v_and_b32 v49, s32, v33
    v_add_u32 v48, 0x00800080, v48
    v_add_u32 v49, 0x00800080, v49
    v_lshrrev_b32 v48, 9, v48
    v_lshrrev_b32 v49, 9, v49
    v_and_or_b32 v32, v48, s34, v32
    v_and_or_b32 v33, v49, s34, v33
    v_and_b32 v48, s32, v34
    v_and_b32 v49, s32, v35
    v_add_u32 v48, 0x00800080, v48
    v_add_u32 v49, 0x00800080, v49
    v_lshrrev_b32 v48, 9, v48
    v_lshrrev_b32 v49, 9, v49
    v_and_or_b32 v34, v48, s34, v34
    v_and_or_b32 v35, v49, s34, v35
    v_and_b32 v48, s32, v36
    v_and_b32 v49, s32, v37
    v_add_u32 v48, 0x00800080, v48
    v_add_u32 v49, 0x00800080, v49
    v_lshrrev_b32 v48, 9, v48
    v_lshrrev_b32 v49, 9, v49
    v_and_or_b32 v36, v48, s34, v36
    v_and_or_b32 v37, v49, s34, v37
    v_and_b32 v48, s32, v38
    v_and_b32 v49, s32, v39
    v_add_u32 v48, 0x00800080, v48
    v_add_u32 v49, 0x00800080, v49
    v_lshrrev_b32 v48, 9, v48
    v_lshrrev_b32 v49, 9, v49
    v_and_or_b32 v38, v48, s34, v38
    v_and_or_b32 v39, v49, s34, v39
    v_and_b32 v48, s32, v40
    v_and_b32 v49, s32, v41
    v_add_u32 v48, 0x00800080, v48
    v_add_u32 v49, 0x00800080, v49
    v_lshrrev_b32 v48, 9, v48
    v_lshrrev_b32 v49, 9, v49
    v_and_or_b32 v40, v48, s34, v40
    v_and_or_b32 v41, v49, s34, v41
    v_and_b32 v48, s32, v42
    v_and_b32 v49, s32, v43
    v_add_u32 v48, 0x00800080, v48
    v_add_u32 v49, 0x00800080, v49
    v_lshrrev_b32 v48, 9, v48
    v_lshrrev_b32 v49, 9, v49
    v_and_or_b32 v42, v48, s34, v42
    v_and_or_b32 v43, v49, s34, v43
    v_and_b32 v48, s32, v44
    v_and_b32 v49, s32, v45
    v_add_u32 v48, 0x00800080, v48
    v_add_u32 v49, 0x00800080, v49
    v_lshrrev_b32 v48, 9, v48
    v_lshrrev_b32 v49, 9, v49
    v_and_or_b32 v44, v48, s34, v44
    v_and_or_b32 v45, v49, s34, v45
    v_and_b32 v48, s32, v46
    v_and_b32 v49, s32, v47
    v_add_u32 v48, 0x00800080, v48
    v_add_u32 v49, 0x00800080, v49
    v_lshrrev_b32 v48, 9, v48
    v_lshrrev_b32 v49, 9, v49
    v_and_or_b32 v46, v48, s34, v46
    v_and_or_b32 v47, v49, s34, v47
    s_cmp_eq_u32 s16, 0
    s_cbranch_scc1 L_ec0
    buffer_store_dwordx4 v[16:19], v7, s[12:15], s28 offen offset:0
    buffer_store_dwordx4 v[20:23], v7, s[12:15], s28 offen offset:1024
L_ec0:
    s_cmp_eq_u32 s16, 1
    s_cbranch_scc1 L_ec1
    buffer_store_dwordx4 v[24:27], v7, s[12:15], s28 offen offset:2048
    buffer_store_dwordx4 v[28:31], v7, s[12:15], s28 offen offset:3072
L_ec1:
    s_cmp_eq_u32 s16, 2
    s_cbranch_scc1 L_ec2
    buffer_store_dwordx4 v[32:35], v7, s[12:15], s29 offen offset:0
    buffer_store_dwordx4 v[36:39], v7, s[12:15], s29 offen offset:1024
L_ec2:
    s_cmp_eq_u32 s16, 3
    s_cbranch_scc1 L_ec3
    buffer_store_dwordx4 v[40:43], v7, s[12:15], s29 offen offset:2048
    buffer_store_dwordx4 v[44:47], v7, s[12:15], s29 offen offset:3072
L_ec3:
L_nofix:
    v_lshlrev_b32 v13, 3, v0
    s_lshr_b32 s49, s21, 2
    s_lshl_b32 s48, s49, 10
    s_and_b32 s42, s21, 3
    s_lshl3_add_u32 s38, s42, s20
    s_add_u32 s48, s48, s38
    s_lshl_b32 s48, s48, 6
    v_and_b32 v8, 7, v0
    v_lshlrev_b32 v8, 3, v8
    v_bfe_u32 v9, v0, 4, 1
    v_lshl_add_u32 v8, v9, 2, v8
    v_lshrrev_b32 v9, 5, v0
    v_lshl_add_u32 v8, v9, 1, v8
    s_lshl_b32 s30, s20, 5
    s_add_u32 s30, s30, s21
    s_mul_i32 s30, s30, 3584
    s_add_u32 s30, s30, 1835008
    v_lshlrev_b32 v59, 7, v0
    s_add_u32 s37, s24, 1
    s_lshr_b32 s31, s23, s37
    s_lshl_b32 s31, s31, 2
    s_lshl3_add_u32 s31, s22, s31
    s_lshl1_add_u32 s37, s24, 1
    s_and_b32 s37, s37, s23
    s_add_u32 s31, s31, s37
    s_lshl_b32 s31, s31, 11
    s_mov_b32 s55, 0x400022
    s_cmp_eq_u32 s20, 1
    s_cselect_b32 s55, 0x1d, s55
    s_cmp_eq_u32 s20, 2
    s_cselect_b32 s55, 0x5c0, s55
    s_cmp_eq_u32 s20, 3
    s_cselect_b32 s55, 0xd800, s55
    s_cmp_eq_u32 s20, 4
    s_cselect_b32 s55, 0x802200, s55
    s_cmp_eq_u32 s20, 5
    s_cselect_b32 s55, 0x1220000, s55
    s_cmp_eq_u32 s20, 6
    s_cselect_b32 s55, 0xe000000, s55
    s_cmp_eq_u32 s20, 7
    s_cselect_b32 s55, 0x1d0000, s55
    s_mov_b32 s34, 80000
    s_and_b32 s36, s33, 0x7ff
    s_mov_b32 s37, s36
    s_cmp_lt_u32 s26, 2
    s_cbranch_scc1 L_pd1
    s_cmp_eq_u32 s2, 230
    s_cbranch_scc1 L_pd2
    s_sleep 8
    s_cmp_eq_u32 s17, 1
    s_cbranch_scc1 L_pd1
    s_sleep 22
L_pd1:
L_pd2:
    s_mov_b32 s32, 0
L_pr:
    s_load_dwordx8 s[60:67], s[52:53], s32
    s_add_u32 s32, s32, 64
    s_waitcnt lgkmcnt(0)
    s_xor_b64 s[38:39], s[60:61], s[36:37]
    s_xor_b64 s[42:43], s[62:63], s[36:37]
    s_or_b64 s[38:39], s[38:39], s[42:43]
    s_xor_b64 s[42:43], s[64:65], s[36:37]
    s_or_b64 s[38:39], s[38:39], s[42:43]
    s_xor_b64 s[42:43], s[66:67], s[36:37]
    s_or_b64 s[38:39], s[38:39], s[42:43]
    s_or_b32 s38, s38, s39
    s_and_b32 s38, s38, 0x7ff
    s_cbranch_scc0 L_pok
    s_cmp_lt_u32 s32, 1024
    s_cbranch_scc1 L_pr
    s_not_b64 s[38:39], s[36:37]
    s_mov_b64 s[88:89], s[38:39]
    s_mov_b64 s[90:91], s[38:39]
    s_mov_b64 s[92:93], s[38:39]
    s_mov_b64 s[94:95], s[38:39]
L_pl:
    s_load_dwordx8 s[88:95], s[52:53], 0 glc
    s_waitcnt lgkmcnt(0)
    s_mov_b64 s[60:61], s[88:89]
    s_mov_b64 s[62:63], s[90:91]
    s_mov_b64 s[64:65], s[92:93]
    s_mov_b64 s[66:67], s[94:95]
    s_xor_b64 s[38:39], s[60:61], s[36:37]
    s_xor_b64 s[42:43], s[62:63], s[36:37]
    s_or_b64 s[38:39], s[38:39], s[42:43]
    s_xor_b64 s[42:43], s[64:65], s[36:37]
    s_or_b64 s[38:39], s[38:39], s[42:43]
    s_xor_b64 s[42:43], s[66:67], s[36:37]
    s_or_b64 s[38:39], s[38:39], s[42:43]
    s_or_b32 s38, s38, s39
    s_and_b32 s38, s38, 0x7ff
    s_cbranch_scc0 L_pok
    s_sub_u32 s34, s34, 1
    s_cmp_lg_u32 s34, 0
    s_cbranch_scc1 L_pl
L_pok:
    s_cmp_eq_u32 s25, 1
    s_cbranch_scc1 L_nox
    s_mov_b32 m0, 98304
    s_and_b32 s38, s60, 0xf800
    buffer_load_dwordx4 v84, s[44:47], s38 offen  lds
    s_add_u32 m0, m0, 1056
    s_and_b32 s38, s61, 0xf800
    buffer_load_dwordx4 v85, s[44:47], s38 offen  lds
    s_add_u32 m0, m0, 1056
    s_and_b32 s38, s62, 0xf800
    buffer_load_dwordx4 v86, s[44:47], s38 offen  lds
    s_add_u32 m0, m0, 1056
    s_and_b32 s38, s63, 0xf800
    buffer_load_dwordx4 v87, s[44:47], s38 offen  lds
    s_add_u32 m0, m0, 1056
    s_and_b32 s38, s64, 0xf800
    buffer_load_dwordx4 v88, s[44:47], s38 offen  lds
    s_add_u32 m0, m0, 1056
    s_and_b32 s38, s65, 0xf800
    buffer_load_dwordx4 v89, s[44:47], s38 offen  lds
    s_add_u32 m0, m0, 1056
    s_and_b32 s38, s66, 0xf800
    buffer_load_dwordx4 v90, s[44:47], s38 offen  lds
    s_add_u32 m0, m0, 1056
    s_and_b32 s38, s67, 0xf800
    buffer_load_dwordx4 v91, s[44:47], s38 offen  lds
L_nox:
    s_mov_b32 exec_hi, 0
    buffer_load_dwordx2 v[14:15], v13, s[56:59], s54 offen sc1
    s_mov_b32 exec_hi, -1
    s_mov_b32 exec_hi, 0
    s_mov_b32 exec_lo, 0xffff
    buffer_load_dword v57, v59, s[56:59], s31 offen nt
    s_mov_b32 exec_lo, s55
    buffer_load_dword v58, v59, s[56:59], s30 offen nt
    s_mov_b64 exec, -1
    s_mov_b32 m0, s49
    s_nop 0
    s_movrels_b32 s40, s60
    s_and_b32 s39, s40, 0xf800
    s_add_u32 s39, s39, s48
    buffer_load_ushort v10, v8, s[44:47], s39 offen
    ds_write_b32 v3, v3 offset:4
    s_mov_b64 exec, -1
    s_waitcnt vmcnt(3)
    v_cmp_eq_u32 vcc, s35, v14
    v_cmp_eq_u32 s[42:43], v15, v6
    s_and_b32 s42, s42, vcc_lo
    s_cmp_eq_u32 s42, -1
    s_cselect_b32 s42, 1, 0
    v_mov_b32 v13, s42
    ds_write_b32 v3, v13 offset:16
    s_cmp_eq_u32 s25, 1
    s_cbranch_scc1 L_nobar
    s_waitcnt lgkmcnt(0)
    s_barrier
L_nobar:
    s_branch T_red
T_redb:
    s_mov_b32 s48, s12
    s_mov_b32 s49, s13
    s_mov_b32 s50, 524288
    s_mov_b32 s51, 0x20000
    s_cmp_lt_u32 s26, 2
    s_cbranch_scc0 L_nocopy
    s_lshr_b32 m0, s27, 3
    s_and_b32 s34, s27, 7
    s_movrels_b32 s31, s60
    s_lshl_b32 s34, s34, 2
    s_bfe_u32 s31, s31, 0x5000b
    s_sub_u32 s31, s31, s34
    s_cmp_eq_u32 s31, s16
    s_cbranch_scc1 L_nocopy
    s_cmp_eq_u32 s16, 0
    s_cbranch_scc0 L_cp0
    buffer_store_dwordx4 v[16:19], v7, s[48:51], s28 offen offset:0
    buffer_store_dwordx4 v[20:23], v7, s[48:51], s28 offen offset:1024
L_cp0:
    s_cmp_eq_u32 s16, 1
    s_cbranch_scc0 L_cp1
    buffer_store_dwordx4 v[24:27], v7, s[48:51], s28 offen offset:2048
    buffer_store_dwordx4 v[28:31], v7, s[48:51], s28 offen offset:3072
L_cp1:
    s_cmp_eq_u32 s16, 2
    s_cbranch_scc0 L_cp2
    buffer_store_dwordx4 v[32:35], v7, s[48:51], s29 offen offset:0
    buffer_store_dwordx4 v[36:39], v7, s[48:51], s29 offen offset:1024
L_cp2:
    s_cmp_eq_u32 s16, 3
    s_cbranch_scc0 L_cp3
    buffer_store_dwordx4 v[40:43], v7, s[48:51], s29 offen offset:2048
    buffer_store_dwordx4 v[44:47], v7, s[48:51], s29 offen offset:3072
L_cp3:
L_nocopy:
    v_mov_b32 v11, s40
    v_ashrrev_i32 v13, 31, v11
    v_not_b32 v13, v13
    v_or_b32 v13, 0x80000000, v13
    v_xor_b32 v11, v11, v13
    v_and_b32 v11, 0xffff0000, v11
    v_mul_f32 v11, 0xbfb8aa3b, v11
    v_exp_f32 v11, v11
    s_nop 0
    v_add_f32 v11, 1.0, v11
    v_rcp_f32 v11, v11
    s_or_b32 s41, s41, s25
    v_cvt_pk_bf16_f32 v11, v11, v11
    v_and_b32 v11, 0xffff0000, v11
    s_waitcnt vmcnt(0)
    v_mov_b32 v28, v12
    v_mov_b32 v29, v12
    v_mov_b32 v30, v12
    v_mov_b32 v31, v12
    s_cmp_eq_u32 s41, 1
    s_cbranch_scc1 L_red
    s_waitcnt lgkmcnt(0)
    s_barrier
    s_barrier
    s_barrier
    s_sleep 14
L_red:
    s_mov_b32 s34, 20000
L_rl:
    buffer_load_dwordx4 v[16:19], v7, s[56:59], s30 offen offset:0 sc1
    buffer_load_dwordx4 v[20:23], v7, s[56:59], s30 offen offset:1024 sc1
    buffer_load_dwordx4 v[24:27], v7, s[56:59], s30 offen offset:2048 sc1
    s_mov_b32 exec_hi, 0
    buffer_load_dwordx4 v[28:31], v7, s[56:59], s30 offen offset:3072 sc1
    s_mov_b32 exec_hi, -1
    s_waitcnt vmcnt(3)
    v_xor_b32 v9, v16, v12
    v_bitop3_b32 v9, v9, v17, v12 bitop3:0xf6
    v_bitop3_b32 v9, v9, v18, v12 bitop3:0xf6
    v_bitop3_b32 v9, v9, v19, v12 bitop3:0xf6
    s_waitcnt vmcnt(2)
    v_bitop3_b32 v9, v9, v20, v12 bitop3:0xf6
    v_bitop3_b32 v9, v9, v21, v12 bitop3:0xf6
    v_bitop3_b32 v9, v9, v22, v12 bitop3:0xf6
    v_bitop3_b32 v9, v9, v23, v12 bitop3:0xf6
    v_pk_add_f32 v[32:33], v[16:17], v[20:21]
    v_pk_add_f32 v[34:35], v[18:19], v[22:23]
    s_waitcnt vmcnt(1)
    v_bitop3_b32 v9, v9, v24, v12 bitop3:0xf6
    v_bitop3_b32 v9, v9, v25, v12 bitop3:0xf6
    v_bitop3_b32 v9, v9, v26, v12 bitop3:0xf6
    v_bitop3_b32 v9, v9, v27, v12 bitop3:0xf6
    v_pk_add_f32 v[32:33], v[32:33], v[24:25]
    v_pk_add_f32 v[34:35], v[34:35], v[26:27]
    s_waitcnt vmcnt(0)
    v_bitop3_b32 v9, v9, v28, v12 bitop3:0xf6
    v_bitop3_b32 v9, v9, v29, v12 bitop3:0xf6
    v_bitop3_b32 v9, v9, v30, v12 bitop3:0xf6
    v_bitop3_b32 v9, v9, v31, v12 bitop3:0xf6
    v_and_b32 v9, 1023, v9
    v_cmp_ne_u32 vcc, 0, v9
    v_pk_add_f32 v[16:17], v[32:33], v[28:29]
    v_pk_add_f32 v[18:19], v[34:35], v[30:31]
    s_cbranch_vccz L_rok
    s_sub_u32 s34, s34, 1
    s_cmp_lg_u32 s34, 0
    s_cbranch_scc1 L_rl
    s_branch L_rok
T_red:
    s_branch T_redb
L_rok:
    s_nop 0
    v_permlane32_swap_b32 v16, v17
    v_permlane32_swap_b32 v18, v19
    v_lshlrev_b32 v10, 16, v10
    v_add_f32 v16, v16, v17
    v_add_f32 v18, v18, v19
    s_nop 1
    v_permlane16_swap_b32 v16, v18
    s_nop 0
    v_add_f32 v16, v16, v18
    s_nop 1
    v_add_f32_dpp v16, v16, v16 row_ror:8 row_mask:0xf bank_mask:0xf
    s_mov_b32 exec_lo, 0x00ff00ff
    s_mov_b32 exec_hi, 0x00ff00ff
    v_cvt_pk_bf16_f32 v16, v16, v16
    v_and_b32 v16, 0xffff0000, v16
    v_mul_f32 v16, v16, v11
    v_cvt_pk_bf16_f32 v16, v16, v16
    v_and_b32 v16, 0xffff0000, v16
    v_fma_f32 v16, v10, 0, v16
    v_add_f32 v16, v10, v16
    v_cvt_pk_bf16_f32 v16, v16, v16
    buffer_store_short v16, v8, s[48:51], s39 offen
    s_cmp_eq_u32 s2, 230
    s_cbranch_scc0 L_nobump
    s_mov_b64 exec, 1
    s_mov_b32 s30, 2801664
    buffer_store_dword v6, v1, s[56:59], s30 offen sc1
L_nobump:
L_end:
    s_endpgm
L_code_end:
.section .rodata,"a"
.p2align 6
.amdhsa_kernel standalone__moe_arch_mod__sampling_kernel
  .amdhsa_next_free_vgpr 120
  .amdhsa_next_free_sgpr 96
  .amdhsa_accum_offset 120
  .amdhsa_group_segment_fixed_size 0
  .amdhsa_kernarg_size 64
  .amdhsa_user_sgpr_count 2
  .amdhsa_user_sgpr_kernarg_segment_ptr 1
  .amdhsa_system_sgpr_workgroup_id_x 1
  .amdhsa_float_denorm_mode_32 3
.end_amdhsa_kernel
```
